```python
import torch

def _softmax(x, axis=-1):
    return torch.softmax(x, dim=axis)
def _gelu(x):
    return torch.nn.functional.gelu(x, approximate="tanh")
def _silu(x):
    return torch.nn.functional.silu(x)
def _sigmoid(x):
    return torch.sigmoid(x)
def _layernorm(x, axis=-1, eps=1e-5):
    m = x.mean(dim=axis, keepdim=True)
    v = x.var(dim=axis, keepdim=True, unbiased=False)
    return (x - m) / torch.sqrt(v + eps)
def _scatter_add(tgt, idx, src, axis=0):
    return tgt.clone().index_add_(axis, idx, src)
def _segment_sum(src, seg, n):
    out = torch.zeros((n,) + src.shape[1:], dtype=src.dtype)
    return out.index_add_(0, seg, src)
def _pad(x, pw):
    flat = tuple(v for pair in reversed(pw) for v in pair)
    return torch.nn.functional.pad(x, flat)

kernel_name = 'concat_heads__spectral_fnet__spectral_fnet__prompt'

def setup_inputs():

    _w = (lambda a: (lambda t: t.to(torch.bfloat16) if t.is_floating_point() else t)(torch.as_tensor(a)))
    def _A_setup():
        B, S, D = 1, 2048, 448
        ns = torch.arange(S)[:, None] * torch.arange(S)[None, :]
        nd = torch.arange(D)[:, None] * torch.arange(D)[None, :]
        Ws_re = torch.cos(-2.0 * torch.pi * ns / S).to(float)
        Ws_im = torch.sin(-2.0 * torch.pi * ns / S).to(float)
        Wd_re = torch.cos(-2.0 * torch.pi * nd / D).to(float)
        Wd_im = torch.sin(-2.0 * torch.pi * nd / D).to(float)
        return {
            "x": _w((lambda *s: torch.randn(*s, dtype=torch.bfloat16) * 0.05)(B, S, D)),
            "dft_seq_re": _w(Ws_re),
            "dft_seq_im": _w(Ws_im),
            "dft_hid_re": _w(Wd_re),
            "dft_hid_im": _w(Wd_im),
        }
    _A_in = _A_setup()

    def _B_setup():
        B, S, D = 1, 2048, 448
        ns = torch.arange(S)[:, None] * torch.arange(S)[None, :]
        nd = torch.arange(D)[:, None] * torch.arange(D)[None, :]
        Ws_re = torch.cos(-2.0 * torch.pi * ns / S).to(float)
        Ws_im = torch.sin(-2.0 * torch.pi * ns / S).to(float)
        Wd_re = torch.cos(-2.0 * torch.pi * nd / D).to(float)
        Wd_im = torch.sin(-2.0 * torch.pi * nd / D).to(float)
        return {
            "x": _w((lambda *s: torch.randn(*s, dtype=torch.bfloat16) * 0.05)(B, S, D)),
            "dft_seq_re": _w(Ws_re),
            "dft_seq_im": _w(Ws_im),
            "dft_hid_re": _w(Wd_re),
            "dft_hid_im": _w(Wd_im),
        }
    _B_in = _B_setup()

    return {
        "A_x": _A_in["x"],
        "A_dft_seq_re": _A_in["dft_seq_re"],
        "A_dft_seq_im": _A_in["dft_seq_im"],
        "A_dft_hid_re": _A_in["dft_hid_re"],
        "A_dft_hid_im": _A_in["dft_hid_im"],
        "B_x": _B_in["x"],
        "B_dft_seq_re": _B_in["dft_seq_re"],
        "B_dft_seq_im": _B_in["dft_seq_im"],
        "B_dft_hid_re": _B_in["dft_hid_re"],
        "B_dft_hid_im": _B_in["dft_hid_im"],
    }

def reference(A_x, A_dft_seq_re, A_dft_seq_im, A_dft_hid_re, A_dft_hid_im, B_x, B_dft_seq_re, B_dft_seq_im, B_dft_hid_re, B_dft_hid_im):
    def _A_ref(x, dft_seq_re, dft_seq_im, dft_hid_re, dft_hid_im):
        a = torch.einsum("bsd,ed->bse", x, dft_hid_re)
        b = torch.einsum("bsd,ed->bse", x, dft_hid_im)
        y = torch.einsum("ts,bse->bte", dft_seq_re, a) - torch.einsum("ts,bse->bte", dft_seq_im, b)
        return y

    def _B_ref(x, dft_seq_re, dft_seq_im, dft_hid_re, dft_hid_im):
        a = torch.einsum("bsd,ed->bse", x, dft_hid_re)
        b = torch.einsum("bsd,ed->bse", x, dft_hid_im)
        y = torch.einsum("ts,bse->bte", dft_seq_re, a) - torch.einsum("ts,bse->bte", dft_seq_im, b)
        return y

    a = _A_ref(A_x, A_dft_seq_re, A_dft_seq_im, A_dft_hid_re, A_dft_hid_im)
    b = _B_ref(B_x, B_dft_seq_re, B_dft_seq_im, B_dft_hid_re, B_dft_hid_im)
    return torch.concatenate([a, b], axis=-1)
```

```asm
; @launch grid=(258,1,1) block=(256,1,1) lds=40880
.amdgcn_target "amdgcn-amd-amdhsa--gfx950"
.text
.globl concat_heads__spectral_fnet__spectral_fnet__prompt_kernel
.p2align 12
.fill 832, 4, 0xbf800000
.p2align 8
.type concat_heads__spectral_fnet__spectral_fnet__prompt_kernel,@function
concat_heads__spectral_fnet__spectral_fnet__prompt_kernel:
  s_load_dwordx2 s[32:33], s[0:1], 0
  s_load_dwordx2 s[34:35], s[0:1], 40
  s_load_dwordx2 s[12:13], s[0:1], 80
  s_load_dwordx2 s[28:29], s[0:1], 88
  s_load_dwordx2 s[24:25], s[0:1], 96
  s_memrealtime s[62:63]
  s_cmp_ge_u32 s2, 258
  s_cbranch_scc1 K_END
  s_setprio 2
  s_getpc_b64 s[10:11]
  v_mul_u32_u24 v1, 24, v0
  global_load_dword v23, v1, s[10:11]
  v_lshrrev_b32 v1, 6, v0
  v_and_b32 v2, 63, v0
  s_and_b32 s8, s2, 7
  v_readfirstlane_b32 s19, v1
  s_mov_b32 s14, 0x380000
  s_mov_b32 s15, 0x20000
  s_mov_b32 s30, 256
  s_mov_b32 s31, 0x20000
  s_mov_b32 s26, 0x208500
  s_mov_b32 s27, 0x20000
  s_mov_b32 s60, 0
  s_mov_b32 s59, 0
  s_mov_b32 s58, s2
  s_cmp_ge_u32 s2, 256
  s_cbranch_scc1 XENTRY
  s_bfe_u32 s17, s2, 0x30004
  s_sub_u32 s18, 16, s8
  s_cmp_eq_u32 s8, 0
  s_cselect_b32 s18, 8, s18
  s_cmp_ge_u32 s2, 128
  s_cselect_b32 s18, s18, s8
  v_and_b32 v3, 0xfc, v0
  v_and_b32 v5, 3, v0
  v_lshl_add_u32 v3, v3, 2, s18
  v_lshlrev_b32 v5, 3, v5
  s_mov_b32 s3, 0x2c1c1000
  v_sub_u32 v4, 2048, v3
  v_bfe_u32 v7, s3, v5, 8
  s_mov_b32 s3, 0x281c0c00
  v_and_b32 v6, 2047, v4
  v_bfe_u32 v5, s3, v5, 8
  s_movk_i32 s3, 896
  v_mad_u32_u24 v3, v3, s3, v7
  v_mad_u32_u24 v4, v4, s3, v5
  v_mad_u32_u24 v6, v6, s3, v5
  s_mul_i32 s37, s17, 56
  s_sub_u32 s38, 840, s37
  s_mov_b32 s22, 0x1c0000
  s_add_u32 s39, s37, 917504
  v_subrev_u32 v4, 917504, v4
  s_lshl_b32 s36, s19, 10
  s_mov_b32 m0, s36
  s_mov_b32 s23, 0x20000
  s_lshl_b32 s61, s2, 2
  s_add_u32 s61, s61, s19
  s_bfe_u32 s16, s2, 0x10003
  v_bfe_u32 v8, v0, 1, 4
  v_lshl_add_u32 v8, v1, 4, v8
  v_and_b32 v9, 1, v0
  v_bfe_u32 v10, v0, 5, 1
  v_and_b32 v11, 0xdf, v0
  v_cmp_eq_u32 vcc, 1, v11
  v_cvt_f32_u32_e64 v14, v10
  s_mov_b32 s3, 0x80008000
  v_cndmask_b32 v11, v8, 64, vcc
  v_cndmask_b32 v12, v9, 0, vcc
  v_cvt_f32_u32 v13, v11
  v_cvt_f32_u32 v12, v12
  v_mul_f32 v13, 0x3c000000, v13
  v_mul_f32 v12, 0x3e800000, v12
  v_mul_f32 v15, 0x41000000, v13
  v_and_b32 v11, 1, v11
  v_fma_f32 v12, v14, v15, v12
  v_mul_lo_u32 v11, v11, s3
  v_add_f32 v14, v13, v13
  v_add_f32 v13, v12, v13
  v_cos_f32 v16, v12
  v_cos_f32 v17, v13
  v_add_f32 v12, v12, v14
  v_add_f32 v13, v13, v14
  v_cvt_pk_bf16_f32 v32, v16, v17
  v_cos_f32 v16, v12
  v_cos_f32 v17, v13
  v_add_f32 v12, v12, v14
  v_add_f32 v13, v13, v14
  v_cvt_pk_bf16_f32 v33, v16, v17
  v_cos_f32 v16, v12
  v_cos_f32 v17, v13
  v_add_f32 v12, v12, v14
  v_add_f32 v13, v13, v14
  v_cvt_pk_bf16_f32 v34, v16, v17
  v_cos_f32 v16, v12
  s_cmp_lg_u32 s61, 7
  s_cbranch_scc1 PUBD
  s_waitcnt lgkmcnt(0)
  s_mul_i32 s54, s62, 0x9e3779b1
  s_lshr_b32 s55, s54, 15
  s_xor_b32 s54, s54, s55
  s_add_u32 s54, s54, s63
  s_mul_i32 s54, s54, 0x85ebca6b
  s_lshr_b32 s55, s54, 16
  s_xor_b32 s54, s54, s55
  s_xor_b32 s55, s54, s62
  s_mul_i32 s55, s55, 0xc2b2ae35
  s_lshr_b32 s56, s55, 16
  s_xor_b32 s55, s55, s56
  s_and_b32 s54, s54, 0xbfffbfff
  s_and_b32 s55, s55, 0xbfffbfff
  s_or_b32 s54, s54, 0x20002000
  s_or_b32 s55, s55, 0x20002000
  v_mov_b32 v24, s54
  v_mov_b32 v25, s55
  v_mov_b32 v26, 0
  v_mov_b32 v27, 0
  v_lshlrev_b32 v29, 7, v2
  s_mov_b64 exec, 3
  buffer_atomic_cmpswap_x2 v[24:27], v29, s[28:31], 0 offen sc1
  s_mov_b64 exec, -1
PUBD:
  s_cmp_eq_u32 s16, 0
  s_waitcnt lgkmcnt(0)
  s_cselect_b32 s20, s32, s34
  s_cselect_b32 s21, s33, s35
  buffer_load_dwordx4 v3, s[20:23], s37 offen  lds
  s_add_u32 m0, s36, 4096
  v_cos_f32 v17, v13
  v_add_f32 v12, v12, v14
  v_add_f32 v13, v13, v14
  v_cvt_pk_bf16_f32 v35, v16, v17
  v_add_f32 v12, v12, v15
  v_add_f32 v13, v13, v15
  v_cos_f32 v16, v12
  v_cos_f32 v17, v13
  v_add_f32 v12, v12, v14
  v_add_f32 v13, v13, v14
  v_cvt_pk_bf16_f32 v36, v16, v17
  v_cos_f32 v16, v12
  v_cos_f32 v17, v13
  v_add_f32 v12, v12, v14
  v_add_f32 v13, v13, v14
  v_cvt_pk_bf16_f32 v37, v16, v17
  v_cos_f32 v16, v12
  v_cos_f32 v17, v13
  v_add_f32 v12, v12, v14
  v_add_f32 v13, v13, v14
  v_cvt_pk_bf16_f32 v38, v16, v17
  v_cos_f32 v16, v12
  v_cos_f32 v17, v13
  v_add_f32 v12, v12, v14
  v_add_f32 v13, v13, v14
  v_cvt_pk_bf16_f32 v39, v16, v17
  v_add_f32 v12, v12, v15
  v_add_f32 v13, v13, v15
  v_cos_f32 v16, v12
  v_cos_f32 v17, v13
  buffer_load_dwordx4 v3, s[20:23], s39 offen  lds
  s_add_u32 m0, s36, 8192
  v_add_f32 v12, v12, v14
  v_add_f32 v13, v13, v14
  v_cvt_pk_bf16_f32 v40, v16, v17
  v_cos_f32 v16, v12
  v_cos_f32 v17, v13
  v_add_f32 v12, v12, v14
  v_add_f32 v13, v13, v14
  v_cvt_pk_bf16_f32 v41, v16, v17
  v_cos_f32 v16, v12
  v_cos_f32 v17, v13
  v_add_f32 v12, v12, v14
  v_add_f32 v13, v13, v14
  v_cvt_pk_bf16_f32 v42, v16, v17
  v_cos_f32 v16, v12
  v_cos_f32 v17, v13
  v_add_f32 v12, v12, v14
  v_add_f32 v13, v13, v14
  v_cvt_pk_bf16_f32 v43, v16, v17
  v_add_f32 v12, v12, v15
  v_add_f32 v13, v13, v15
  v_cos_f32 v16, v12
  v_cos_f32 v17, v13
  v_add_f32 v12, v12, v14
  v_add_f32 v13, v13, v14
  v_cvt_pk_bf16_f32 v44, v16, v17
  v_cos_f32 v16, v12
  v_cos_f32 v17, v13
  v_add_f32 v12, v12, v14
  v_add_f32_e64 v13, v13, v14
  v_cvt_pk_bf16_f32 v45, v16, v17
  buffer_load_dwordx4 v6, s[20:23], s38 offen  lds
  s_add_u32 m0, s36, 12288
  v_cos_f32 v16, v12
  v_cos_f32 v17, v13
  v_add_f32 v12, v12, v14
  v_add_f32 v13, v13, v14
  v_cvt_pk_bf16_f32 v46, v16, v17
  v_cos_f32 v16, v12
  v_cos_f32 v17, v13
  v_add_f32 v12, v12, v14
  v_add_f32 v13, v13, v14
  v_cvt_pk_bf16_f32 v47, v16, v17
  v_xor_b32 v48, v11, v32
  v_xor_b32 v49, v11, v33
  v_xor_b32 v50, v11, v34
  v_xor_b32 v51, v11, v35
  v_xor_b32 v52, v11, v36
  v_xor_b32 v53, v11, v37
  v_xor_b32 v54, v11, v38
  v_xor_b32 v55, v11, v39
  v_xor_b32 v56, v11, v40
  v_xor_b32 v57, v11, v41
  v_xor_b32 v58, v11, v42
  v_xor_b32 v59, v11, v43
  v_xor_b32 v60, v11, v44
  v_xor_b32 v61, v11, v45
  v_xor_b32 v62, v11, v46
  v_xor_b32 v63, v11, v47
  v_bfe_u32 v16, v0, 4, 1
  v_bfe_u32 v17, v0, 1, 1
  v_lshl_or_b32 v16, v9, 1, v16
  v_bfe_u32 v12, v0, 2, 2
  buffer_load_dwordx4 v4, s[20:23], s38 offen  lds
  v_lshl_or_b32 v16, v16, 1, v17
  v_lshl_add_u32 v17, v10, 3, v12
  v_lshlrev_b32 v16, 3, v16
  v_lshl_add_u32 v18, v17, 6, v16
  v_xor_b32 v19, 48, v18
  s_movk_i32 s3, 16640
  v_mul_u32_u24 v20, s3, v8
  s_mul_i32 s41, s16, 1064960
  s_add_u32 s41, s41, 128
  s_lshl_b32 s3, s17, 11
  s_lshl_b32 s40, s18, 7
  v_lshl_add_u32 v21, v9, 3, v20
  v_lshl_add_u32 v20, v9, 5, v20
  s_add_u32 s40, s40, s3
  s_add_u32 s40, s40, s41
  v_lshl_add_u32 v21, v10, 31, v21
  v_lshl_add_u32 v20, v10, 4, v20
  s_lshl_b32 s3, s18, 4
  s_add_u32 s41, s41, s3
  s_add_u32 s41, s41, 16384
  v_xor_b32 v9, 1, v9
  v_lshlrev_b32 v9, 4, v9
XTRA:
  s_and_b32 s43, s2, 3
  s_lshl_b32 s43, s43, 4
  s_lshr_b32 s3, s2, 4
  s_add_u32 s43, s43, s3
  s_bfe_u32 s42, s2, 0x10002
  s_bfe_u32 s44, s2, 0x10003
  s_cmp_ge_u32 s2, 256
  s_cselect_b32 s43, 0, s43
  s_cselect_b32 s42, s8, s42
  s_lshl_b32 s3, s42, 6
  s_add_u32 s3, s3, s43
  s_mul_i32 s3, s3, 16640
  s_add_u32 s3, s3, 128
  s_lshl_b32 s45, s19, 12
  s_add_u32 s51, s45, 16384
  s_add_u32 s45, s45, s3
  s_add_u32 s46, s3, 16384
  v_lshrrev_b32 v5, 3, v2
  v_bfe_u32 v6, v0, 4, 1
  v_and_b32 v7, 7, v0
  v_lshlrev_b32 v6, 2, v6
  v_lshlrev_b32 v3, 7, v5
  v_xor_b32 v6, v6, v7
  v_lshlrev_b32 v242, 4, v2
  v_lshl_add_u32 v216, v6, 4, v3
  s_lshl_b32 s47, s44, 10
  s_add_u32 s47, s47, s43
  s_cmp_eq_u32 s44, 0
  s_cselect_b32 s54, 64, 0
  s_mov_b32 s55, 0xffff
  s_cselect_b32 s49, 0xffff0000, s55
  s_cmp_ge_u32 s2, 256
  s_cselect_b32 s54, 1024, s54
  s_cselect_b32 s49, s55, s49
  s_cmp_eq_u32 s43, 0
  s_cselect_b32 s47, s54, s47
  s_cselect_b32 s49, s49, -1
  s_cselect_b32 s48, 0, 0xbe800000
  v_bfe_u32 v236, v0, 4, 2
  v_and_b32 v237, 15, v0
  v_bfe_u32 v6, v0, 3, 1
  v_lshlrev_b32 v7, 1, v236
  v_cvt_f32_u32 v6, v6
  v_cvt_f32_u32 v238, v7
  v_mul_f32 v239, 0x3e800000, v6
  s_mov_b32 s56, 0x01010101
  s_mov_b32 s57, s56
  s_mov_b32 s64, 0xff0000ff
  s_mov_b32 s65, s64
  s_mov_b32 s66, 0xffff
  s_cmp_ge_u32 s2, 256
  s_cbranch_scc1 XDONE
  s_nop 0
  s_waitcnt vmcnt(3)
  s_barrier
  ds_read_b64_tr_b16 v[64:65], v18 offset:0
  ds_read_b64_tr_b16 v[66:67], v18 offset:256
  ds_read_b64_tr_b16 v[68:69], v18 offset:1024
  ds_read_b64_tr_b16 v[70:71], v18 offset:1280
  ds_read_b64_tr_b16 v[72:73], v18 offset:2048
  ds_read_b64_tr_b16 v[74:75], v18 offset:2304
  ds_read_b64_tr_b16 v[76:77], v18 offset:3072
  ds_read_b64_tr_b16 v[78:79], v18 offset:3328
  s_waitcnt lgkmcnt(6)
  v_mfma_f32_32x32x16_bf16 v[128:143], v[64:67], v[32:35], 0
  s_nop 0
  s_waitcnt vmcnt(2)
  s_barrier
  ds_read_b64_tr_b16 v[80:81], v18 offset:4096
  ds_read_b64_tr_b16 v[82:83], v18 offset:4352
  ds_read_b64_tr_b16 v[84:85], v18 offset:5120
  ds_read_b64_tr_b16 v[86:87], v18 offset:5376
  ds_read_b64_tr_b16 v[88:89], v18 offset:6144
  ds_read_b64_tr_b16 v[90:91], v18 offset:6400
  ds_read_b64_tr_b16 v[92:93], v18 offset:7168
  ds_read_b64_tr_b16 v[94:95], v18 offset:7424
  buffer_load_dwordx2 v[218:219], off, s[28:31], 0
  s_waitcnt lgkmcnt(12)
  v_mfma_f32_32x32x16_bf16 v[128:143], v[68:71], v[36:39], v[128:143]
  s_waitcnt lgkmcnt(10)
  v_mfma_f32_32x32x16_bf16 v[128:143], v[72:75], v[40:43], v[128:143]
  s_waitcnt lgkmcnt(8)
  v_mfma_f32_32x32x16_bf16 v[128:143], v[76:79], v[44:47], v[128:143]
  s_waitcnt lgkmcnt(6)
  v_mfma_f32_32x32x16_bf16 v[128:143], v[80:83], v[48:51], v[128:143]
  s_waitcnt vmcnt(2)
  s_barrier
  ds_read_b64_tr_b16 v[96:97], v19 offset:8192
  ds_read_b64_tr_b16 v[98:99], v19 offset:8448
  ds_read_b64_tr_b16 v[100:101], v19 offset:9216
  ds_read_b64_tr_b16 v[102:103], v19 offset:9472
  ds_read_b64_tr_b16 v[104:105], v19 offset:10240
  ds_read_b64_tr_b16 v[106:107], v19 offset:10496
  ds_read_b64_tr_b16 v[108:109], v19 offset:11264
  ds_read_b64_tr_b16 v[110:111], v19 offset:11520
  s_waitcnt lgkmcnt(12)
  v_mfma_f32_32x32x16_bf16 v[128:143], v[84:87], v[52:55], v[128:143]
  s_waitcnt lgkmcnt(10)
  v_mfma_f32_32x32x16_bf16 v[128:143], v[88:91], v[56:59], v[128:143]
  s_waitcnt lgkmcnt(8)
  v_mfma_f32_32x32x16_bf16 v[128:143], v[92:95], v[60:63], v[128:143]
  s_waitcnt lgkmcnt(6)
  v_mfma_f32_32x32x16_bf16 v[144:159], v[96:99], v[32:35], 0
  s_waitcnt vmcnt(1)
  s_barrier
  ds_read_b64_tr_b16 v[112:113], v19 offset:12288
  ds_read_b64_tr_b16 v[114:115], v19 offset:12544
  ds_read_b64_tr_b16 v[116:117], v19 offset:13312
  ds_read_b64_tr_b16 v[118:119], v19 offset:13568
  ds_read_b64_tr_b16 v[120:121], v19 offset:14336
  ds_read_b64_tr_b16 v[122:123], v19 offset:14592
  ds_read_b64_tr_b16 v[124:125], v19 offset:15360
  ds_read_b64_tr_b16 v[126:127], v19 offset:15616
  s_waitcnt lgkmcnt(12)
  v_mfma_f32_32x32x16_bf16 v[144:159], v[100:103], v[36:39], v[144:159]
  s_waitcnt lgkmcnt(10)
  v_mfma_f32_32x32x16_bf16 v[144:159], v[104:107], v[40:43], v[144:159]
  s_waitcnt lgkmcnt(8)
  v_mfma_f32_32x32x16_bf16 v[144:159], v[108:111], v[44:47], v[144:159]
  s_waitcnt lgkmcnt(6)
  v_mfma_f32_32x32x16_bf16 v[144:159], v[112:115], v[48:51], v[144:159]
  s_waitcnt vmcnt(0)
  v_cmp_eq_u32 vcc, 0, v218
  s_cbranch_vccnz NWAIT
NOK:
  s_waitcnt lgkmcnt(4)
  v_mfma_f32_32x32x16_bf16 v[144:159], v[116:119], v[52:55], v[144:159]
  s_mov_b32 vcc_lo, 0
  s_mov_b32 vcc_hi, -1
  v_cndmask_b32 v22, v218, v219, vcc
  s_waitcnt lgkmcnt(2)
  v_mfma_f32_32x32x16_bf16 v[144:159], v[120:123], v[56:59], v[144:159]
  v_lshlrev_b32 v22, v9, v22
  v_and_b32 v22, 0xffff0000, v22
  s_cmp_lg_u32 s17, 0
  s_cbranch_scc1 NOC0
  v_cvt_pk_bf16_f32 v17, v22, v128
  buffer_store_dword v17, v21, s[24:27], s41 offen sc1
NOC0:
  s_waitcnt lgkmcnt(0)
  v_mfma_f32_32x32x16_bf16 v[144:159], v[124:127], v[60:63], v[144:159]
  s_mov_b32 vcc_lo, 0xff00ff00
  s_mov_b32 vcc_hi, 0xff00ff00
  v_cndmask_b32 v240, v218, v219, vcc
  v_cndmask_b32 v241, v218, v219, vcc
  s_and_b32 s3, s61, 0xfffffffb
  s_cmp_lg_u32 s3, 8
  s_cbranch_scc1 PROGD
  s_lshl_b32 s3, s61, 7
  s_add_u32 s3, s3, 2129024
  v_lshlrev_b32 v17, 7, v2
  s_mov_b64 exec, 15
  buffer_store_dwordx2 v[218:219], v17, s[24:27], s3 offen sc1
  s_mov_b64 exec, -1
PROGD:
  s_nop 5
  v_add_f32 v129, v129, v151
  v_cvt_pk_bf16_f32 v24, v22, v129
  v_add_f32 v130, v130, v150
  v_add_f32 v131, v131, v149
  v_cvt_pk_bf16_f32 v25, v130, v131
  v_add_f32 v132, v132, v148
  v_add_f32 v133, v133, v147
  v_cvt_pk_bf16_f32 v26, v132, v133
  v_add_f32 v134, v134, v146
  v_add_f32 v135, v135, v145
  v_cvt_pk_bf16_f32 v27, v134, v135
  buffer_store_dwordx4 v[24:27], v20, s[24:27], s40 offen offset:0 sc1
  v_add_f32 v136, v136, v158
  v_cvt_pk_bf16_f32 v28, v22, v136
  v_add_f32 v137, v137, v157
  v_add_f32 v138, v138, v156
  v_cvt_pk_bf16_f32 v29, v137, v138
  v_add_f32 v139, v139, v155
  v_add_f32 v140, v140, v154
  v_cvt_pk_bf16_f32 v30, v139, v140
  v_add_f32 v141, v141, v153
  v_add_f32 v142, v142, v152
  v_cvt_pk_bf16_f32 v31, v141, v142
  buffer_store_dwordx4 v[28:31], v20, s[24:27], s40 offen offset:64 sc1
XDONE:
  v_and_b32 v7, 7, v0
  v_lshl_add_u32 v11, v7, 7, s47
  v_bfe_u32 v12, v0, 3, 3
  v_cvt_f32_u32 v11, v11
  v_bfe_u32 v13, v0, 4, 1
  v_mul_f32 v11, 0x3a000000, v11
  v_lshlrev_b32_e64 v12, 7, v12
  v_fma_f32 v14, v11, v238, v239
  v_lshl_add_u32 v12, v13, 6, v12
  v_mul_f32 v15, 0x40e00000, v11
  v_lshl_add_u32 v12, v7, 3, v12
  v_lshrrev_b32 v13, 2, v2
  v_add_u32 v196, s51, v12
  v_lshlrev_b32 v13, 3, v13
  v_xor_b32 v197, 64, v196
  v_add_u32 v13, 32768, v13
  s_mov_b32 vcc_lo, 0xcccccccc
  s_mov_b32 vcc_hi, 0xcccccccc
  v_add_u32 v12, 128, v13
  v_cndmask_b32 v217, v13, v196, vcc
  v_cndmask_b32 v244, v12, v196, vcc
  v_add_f32 v12, s48, v14
  v_cos_f32 v13, v14
  v_cos_f32 v12, v12
  v_add_f32 v14, v14, v11
  v_cvt_pk_bf16_f32 v160, v13, v12
  v_and_b32 v160, s49, v160
  v_add_f32 v12, s48, v14
  v_cos_f32 v13, v14
  v_cos_f32 v12, v12
  v_add_f32 v14, v14, v15
  v_cvt_pk_bf16_f32 v161, v13, v12
  v_and_b32 v161, s49, v161
  v_add_f32 v12, s48, v14
  v_cos_f32 v13, v14
  v_cos_f32 v12, v12
  v_add_f32 v14, v14, v11
  v_cvt_pk_bf16_f32 v162, v13, v12
  v_and_b32 v162, s49, v162
  v_add_f32 v12, s48, v14
  v_cos_f32 v13, v14
  v_cos_f32 v12, v12
  v_add_f32 v14, v14, v11
  v_cvt_pk_bf16_f32 v163, v13, v12
  v_and_b32 v163, s49, v163
  v_lshrrev_b32 v7, 1, v236
  v_and_b32 v11, 1, v236
  v_lshlrev_b32 v7, 5, v7
  v_and_b32 v12, 7, v0
  v_lshl_add_u32 v7, v11, 3, v7
  s_mov_b32 s4, 0xff00ff00
  s_mov_b32 s5, s4
  v_sub_u32 v13, 14, v12
  v_add_u32 v7, 33024, v7
  v_sub_u32 v14, 7, v12
  v_add_u32 v15, 7, v12
  v_cndmask_b32 v12, v12, v13, s[4:5]
  s_mov_b32 s6, 0x00800080
  s_mov_b32 s7, s6
  v_cndmask_b32 v13, v15, v14, s[4:5]
  s_movk_i32 s3, 1104
  v_lshrrev_b32 v14, 1, v12
  v_cndmask_b32 v13, v13, 0, s[6:7]
  v_and_b32 v16, 8, v12
  v_and_b32 v12, 1, v12
  v_lshrrev_b32 v15, 1, v13
  v_and_b32 v17, 8, v13
  v_and_b32 v13, 1, v13
  v_xor_b32 v16, v16, v7
  v_xor_b32 v17, v17, v7
  v_mad_u32_u24 v14, v14, s3, v16
  v_mad_u32_u24 v15, v15, s3, v17
  s_lshl_b32 s3, s19, 7
  v_lshl_add_u32 v14, v12, 4, v14
  v_lshl_add_u32 v15, v13, 4, v15
  s_sub_u32 s54, 960, s3
  v_mov_b32 v12, s3
  v_mov_b32_e64 v13, s54
  v_add_u32 v17, 512, v15
  v_mov_b32 v16, 0xffffffc0
  v_cndmask_b32 v13, v12, v13, s[4:5]
  v_cndmask_b32 v15, v15, v17, s[6:7]
  v_cndmask_b32 v16, 64, v16, s[4:5]
  s_mov_b32 s6, 0x80008000
  s_mov_b32 s7, s6
  v_add_u32 v12, 64, v12
  v_add_u32_e64 v198, v14, v13
  v_mov_b32 v17, 40752
  v_cndmask_b32 v13, v13, v12, s[6:7]
  v_cndmask_b32 v12, v16, 64, s[6:7]
  v_add_u32 v199, v15, v13
  v_add_u32 v200, v198, v16
  s_cmp_eq_u32 s19, 3
  s_cselect_b32 s4, s6, 0
  s_mov_b32 s5, 0
  s_mov_b32 s6, 0
  s_mov_b32 s7, s4
  v_add_u32 v201, v199, v12
  v_add_u32 v12, 32, v7
  s_mov_b32 vcc_lo, 0x00020002
  s_mov_b32 vcc_hi, 0
  v_cndmask_b32 v201, v201, v12, s[4:5]
  v_cndmask_b32 v202, v17, v7, vcc
  v_cndmask_b32 v201, v201, v17, s[6:7]
  v_and_b32 v7, 3, v0
  v_lshl_add_u32 v7, v1, 2, v7
  v_bfe_u32 v11, v0, 2, 1
  v_cvt_f32_u32 v7, v7
  v_cvt_f32_u32 v11, v11
  v_mul_f32 v6, 0x3b124925, v7
  v_mul_f32 v7, 0x3d800000, v7
  v_add_f32 v13, 0.5, v6
  v_mul_f32 v12, v238, v7
  v_fma_f32 v13, v11, v13, v239
  v_mul_f32 v14, 0x41600000, v6
  v_add_f32 v13, v13, v12
  v_add_f32 v14, v14, v12
  v_and_b32 v15, 1, v0
  v_add_f32 v6, v6, v6
  v_bfrev_b32 v16, 1
  v_lshlrev_b32 v15, 4, v15
  s_mov_b32 s4, 0x0f000f00
  s_mov_b32 s5, s4
  v_lshrrev_b32 v15, v15, v16
  s_mov_b32 s6, 0x000f000f
  s_mov_b32 s7, s6
  v_cndmask_b32 v14, v13, v14, s[4:5]
  v_add_f32 v17, v14, v7
  v_cos_f32 v11, v14
  v_sin_f32 v12, v14
  v_cos_f32 v16, v17
  v_sin_f32 v17, v17
  v_cvt_pk_bf16_f32 v164, v11, v12
  v_add_f32 v13, v13, v6
  v_cvt_pk_bf16_f32 v165, v16, v17
  v_xor_b32 v166, v15, v164
  v_xor_b32 v167, v15, v165
  v_cndmask_b32 v166, v166, v164, s[4:5]
  v_cndmask_b32 v167, v167, v165, s[4:5]
  v_lshlrev_b32 v16, 31, v0
  v_cndmask_b32 v166, v166, 0, s[6:7]
  v_cndmask_b32 v167, v167, 0, s[6:7]
  v_or_b32 v16, 0x3f003f80, v16
  v_cndmask_b32 v164, v164, 0, s[4:5]
  s_mov_b64 vcc, 15
  v_cndmask_b32 v165, v165, 0, s[4:5]
  v_cndmask_b32 v164, v164, v16, vcc
  v_add_f32 v17, v13, v7
  v_cos_f32 v11, v13
  v_sin_f32 v12, v13
  v_cos_f32 v16, v17
  v_sin_f32 v17, v17
  v_cvt_pk_bf16_f32 v168, v11, v12
  v_add_f32 v13, v13, v6
  v_cvt_pk_bf16_f32 v169, v16, v17
  v_xor_b32 v170, v15, v168
  v_xor_b32 v171, v15, v169
  v_add_f32 v17, v13, v7
  v_cos_f32 v11, v13
  v_sin_f32 v12, v13
  v_cos_f32 v16, v17
  v_sin_f32 v17, v17
  v_cvt_pk_bf16_f32 v172, v11, v12
  v_add_f32 v13, v13, v6
  v_cvt_pk_bf16_f32 v173, v16, v17
  v_xor_b32 v174, v15, v172
  v_xor_b32 v175, v15, v173
  v_add_f32 v17, v13, v7
  v_cos_f32 v11, v13
  v_sin_f32 v12, v13
  v_cos_f32 v16, v17
  v_sin_f32 v17, v17
  v_cvt_pk_bf16_f32 v176, v11, v12
  v_add_f32 v13, v13, v6
  v_cvt_pk_bf16_f32 v177, v16, v17
  v_xor_b32 v178, v15, v176
  v_xor_b32 v179, v15, v177
  v_add_f32 v17, v13, v7
  v_cos_f32 v11, v13
  v_sin_f32 v12, v13
  v_cos_f32 v16, v17
  v_sin_f32 v17, v17
  v_cvt_pk_bf16_f32 v180, v11, v12
  v_add_f32 v13, v13, v6
  v_cvt_pk_bf16_f32 v181, v16, v17
  v_xor_b32 v182, v15, v180
  v_xor_b32 v183, v15, v181
  v_add_f32 v17, v13, v7
  v_cos_f32 v11, v13
  v_sin_f32 v12, v13
  v_cos_f32 v16, v17
  v_sin_f32 v17, v17
  v_cvt_pk_bf16_f32 v184, v11, v12
  v_add_f32 v13, v13, v6
  v_cvt_pk_bf16_f32 v185, v16, v17
  v_xor_b32 v186, v15, v184
  v_xor_b32 v187, v15, v185
  v_add_f32 v17, v13, v7
  v_cos_f32 v11, v13
  v_sin_f32 v12, v13
  v_cos_f32 v16, v17
  v_sin_f32 v17, v17
  v_cvt_pk_bf16_f32 v188, v11, v12
  v_add_f32 v13, v13, v6
  v_cvt_pk_bf16_f32 v189, v16, v17
  v_xor_b32 v190, v15, v188
  v_xor_b32 v191, v15, v189
  v_cvt_f32_u32 v7, v237
  v_and_b32 v11, 1, v236
  v_lshrrev_b32 v12, 1, v236
  v_mul_f32 v6, 0x3d124925, v7
  v_cvt_f32_u32 v11, v11
  v_cvt_f32_u32 v12, v12
  v_mul_f32 v7, 0.5, v7
  v_mul_f32 v12, 0xbe800000, v12
  s_mov_b32 vcc_lo, 0
  v_fma_f32 v12, v11, v6, v12
  s_mov_b32 vcc_hi, 0xffff
  v_add_f32 v6, v6, v6
  v_cndmask_b32 v7, v12, v7, vcc
  v_cos_f32 v16, v7
  v_add_f32 v12, v12, v6
  v_cos_f32 v17, v12
  v_add_f32 v12, v12, v6
  v_cvt_pk_bf16_f32 v192, v16, v17
  v_cos_f32 v16, v12
  v_add_f32 v12, v12, v6
  v_cos_f32 v17, v12
  v_add_f32 v12, v12, v6
  v_cvt_pk_bf16_f32 v193, v16, v17
  v_cos_f32 v16, v12
  v_add_f32 v12, v12, v6
  v_cos_f32 v17, v12
  v_add_f32 v12, v12, v6
  v_cvt_pk_bf16_f32 v194, v16, v17
  v_cos_f32 v16, v12
  v_add_f32 v12, v12, v6
  v_cvt_pk_bf16_f32 v195, v16, 0
  v_lshlrev_b32 v7, 3, v2
  v_and_b32 v6, 7, v0
  s_movk_i32 s3, 912
  v_add_u32 v203, 33024, v7
  v_mul_u32_u24 v6, s3, v6
  v_bfe_u32 v11, v0, 3, 1
  s_lshl_b32 s3, s19, 3
  v_mul_u32_u24 v12, 448, v11
  s_add_u32 s3, s3, 0
  v_lshl_add_u32 v6, v236, 7, v6
  v_cvt_f32_u32 v11, v11
  v_add3_u32 v204, s3, v6, v12
  v_fma_f32 v205, v11, 2.0, -1.0
  s_mov_b32 vcc_lo, 0
  s_mov_b32 vcc_hi, 0xffff0000
  v_mov_b32 v6, 40752
  v_cndmask_b32 v243, v204, v6, vcc
  v_xor_b32 v245, 8, v203
  v_mov_b32 v220, 0
  v_mov_b32 v221, 0
  v_mov_b32 v222, 0
  v_mov_b32 v223, 0
  v_mov_b32 v224, 0
  v_mov_b32 v225, 0
  v_mov_b32 v226, 0
  v_mov_b32 v227, 0
  v_mov_b32 v228, 0
  v_mov_b32 v229, 0
  v_mov_b32 v230, 0
  v_mov_b32 v231, 0
  v_mov_b32 v232, 0
  v_mov_b32 v233, 0
  v_mov_b32 v234, 0
  v_mov_b32 v235, 0
  s_cmp_ge_u32 s58, 256
  s_cbranch_scc1 XSK
LOAD2:
  s_add_u32 m0, s51, 0
  s_cmp_lg_u32 s19, 3
  buffer_load_dwordx4 v216, s[24:27], s45 offen offset:0 sc1 lds
  buffer_load_dwordx4 v216, s[24:27], s45 offen offset:1024 sc1 lds
  buffer_load_dwordx4 v216, s[24:27], s45 offen offset:2048 sc1 lds
  buffer_load_dwordx4 v216, s[24:27], s45 offen offset:3072 sc1 lds
  s_cbranch_scc1 NCF
  s_mov_b32 m0, 32768
  s_mov_b64 exec, 0xffff
  buffer_load_dwordx4 v242, s[24:27], s46 offen sc1 lds
  s_mov_b64 exec, -1
NCF:
XSK:
  s_movk_i32 s4, 1171
  s_movk_i32 s5, 912
  s_movk_i32 s6, 1792
  s_cmp_ge_u32 s2, 256
  s_cselect_b32 s7, 56, 448
  s_cselect_b32 s52, 0, 448
  s_mul_i32 s53, s42, 896
  v_bfrev_b32 v17, 1
  v_add_u32 v7, 0, v0
  v_mul_u32_u24 v6, s4, v7
  v_cmp_gt_u32 vcc, s7, v7
  v_lshrrev_b32 v6, 16, v6
  v_mul_u32_u24 v11, 56, v6
  v_mul_u32_u24 v12, s5, v6
  v_sub_u32 v11, v7, v11
  v_lshl_add_u32 v6, v6, 7, s47
  v_lshlrev_b32 v11, 4, v11
  v_add_u32 v12, 0, v12
  v_mad_u32_u24 v13, v6, s6, v11
  v_sub_u32 v14, 2048, v6
  v_cndmask_b32 v209, v17, v13, vcc
  v_cmp_eq_u32 vcc, 0, v11
  v_add_u32 v206, v12, v11
  v_sub_u32_e64 v15, v12, v11
  v_mad_u32_u24 v13, v14, s6, v11
  v_add_u32 v16, 896, v15
  v_add_u32 v207, 880, v15
  v_cndmask_b32 v208, v16, v12, vcc
  v_cmp_gt_u32 vcc, s52, v7
  v_cmp_ne_u32 s[54:55], 0, v6
  s_and_b64 vcc, vcc, s[54:55]
  v_cndmask_b32 v210, v17, v13, vcc
  v_add_u32 v7, 256, v0
  v_mul_u32_u24 v6, s4, v7
  v_cmp_gt_u32 vcc, s7, v7
  v_lshrrev_b32 v6, 16, v6
  v_mul_u32_u24 v11, 56, v6
  v_mul_u32_u24 v12, s5, v6
  v_sub_u32 v11, v7, v11
  v_lshl_add_u32 v6, v6, 7, s47
  v_lshlrev_b32 v11, 4, v11
  v_add_u32 v12, 0, v12
  v_mad_u32_u24 v13, v6, s6, v11
  v_sub_u32 v14, 2048, v6
  v_cndmask_b32 v214, v17, v13, vcc
  v_cmp_eq_u32 vcc, 0, v11
  v_add_u32 v211, v12, v11
  v_sub_u32 v15, v12, v11
  v_mad_u32_u24 v13, v14, s6, v11
  v_add_u32 v16, 896, v15
  v_add_u32 v212, 880, v15
  v_cndmask_b32 v213, v16, v12, vcc
  v_cmp_gt_u32 vcc, s52, v7
  v_cmp_ne_u32 s[54:55], 0, v6
  s_and_b64 vcc, vcc, s[54:55]
  v_cndmask_b32 v215, v17, v13, vcc
  s_cmp_ge_u32 s58, 256
  s_cbranch_scc1 XW1
P2L:
  s_cmp_eq_u32 s19, 3
  s_cbranch_scc1 SA3
  s_waitcnt vmcnt(2)
  ds_read_b64_tr_b16 v[96:97], v196 offset:0
  ds_read_b64_tr_b16 v[98:99], v196 offset:1024
  ds_read_b64_tr_b16 v[100:101], v197 offset:0
  ds_read_b64_tr_b16 v[102:103], v197 offset:1024
  s_waitcnt vmcnt(0)
  ds_read_b64_tr_b16 v[104:105], v196 offset:2048
  ds_read_b64_tr_b16 v[106:107], v196 offset:3072
  ds_read_b64_tr_b16 v[108:109], v197 offset:2048
  ds_read_b64_tr_b16 v[110:111], v197 offset:3072
  s_waitcnt lgkmcnt(4)
  v_mfma_f32_16x16x32_bf16 v[112:115], v[160:163], v[96:99], 0
  v_mfma_f32_16x16x32_bf16 v[116:119], v[160:163], v[100:103], 0
  s_waitcnt lgkmcnt(2)
  v_mfma_f32_16x16x32_bf16 v[120:123], v[160:163], v[104:107], 0
  s_waitcnt lgkmcnt(0)
  v_mfma_f32_16x16x32_bf16 v[124:127], v[160:163], v[108:111], 0
  s_mov_b64 exec, s[56:57]
  v_cmpx_eq_u64 vcc, v[96:97], v[240:241]
  v_cmpx_eq_u64 vcc, v[98:99], v[240:241]
  v_cmpx_eq_u64 vcc, v[100:101], v[240:241]
  v_cmpx_eq_u64 vcc, v[102:103], v[240:241]
  v_cmpx_eq_u64 vcc, v[104:105], v[240:241]
  v_cmpx_eq_u64 vcc, v[106:107], v[240:241]
  v_cmpx_eq_u64 vcc, v[108:109], v[240:241]
  v_cmpx_eq_u64 vcc, v[110:111], v[240:241]
  s_cmp_eq_u64 exec, s[56:57]
  s_cbranch_scc0 RETRY
  s_not_b64 exec, s[56:57]
  v_cvt_pk_bf16_f32 v88, v112, v113
  v_cvt_pk_bf16_f32 v89, v114, v115
  ds_write_b64 v198, v[88:89]
  v_cvt_pk_bf16_f32 v90, v116, v117
  v_cvt_pk_bf16_f32 v91, v118, v119
  ds_write_b64 v199, v[90:91]
  v_cvt_pk_bf16_f32 v92, v120, v121
  v_cvt_pk_bf16_f32 v93, v122, v123
  ds_write_b64 v200, v[92:93]
  v_cvt_pk_bf16_f32 v94, v124, v125
  v_cvt_pk_bf16_f32 v95, v126, v127
  ds_write_b64 v201, v[94:95]
  s_mov_b64 exec, -1
  s_branch P2OK
RETRY:
  s_mov_b64 exec, -1
  s_add_u32 s60, s60, 0x100
  s_cmp_lt_u32 s60, 0x10000000
  s_cbranch_scc1 LOAD2
  s_mov_b32 s56, 0
  s_mov_b32 s57, 0
  s_branch P2L
SA3:
  s_waitcnt vmcnt(3)
  ds_read_b64_tr_b16 v[96:97], v196 offset:0
  ds_read_b64_tr_b16 v[98:99], v196 offset:1024
  ds_read_b64_tr_b16 v[100:101], v197 offset:0
  ds_read_b64_tr_b16 v[102:103], v197 offset:1024
  s_waitcnt vmcnt(1)
  ds_read_b64_tr_b16 v[104:105], v196 offset:2048
  ds_read_b64_tr_b16 v[106:107], v196 offset:3072
  ds_read_b64_tr_b16 v[108:109], v197 offset:2048
  ds_read_b64_tr_b16 v[110:111], v197 offset:3072
  s_waitcnt lgkmcnt(4)
  v_mfma_f32_16x16x32_bf16 v[112:115], v[160:163], v[96:99], 0
  v_mfma_f32_16x16x32_bf16 v[116:119], v[160:163], v[100:103], 0
  s_waitcnt vmcnt(0)
  ds_read_b64_tr_b16 v[80:81], v217 offset:0
  ds_read_b64_tr_b16 v[82:83], v244 offset:0
  s_waitcnt lgkmcnt(2)
  v_mfma_f32_16x16x32_bf16 v[120:123], v[160:163], v[104:107], 0
  v_mfma_f32_16x16x32_bf16 v[124:127], v[160:163], v[108:111], 0
  s_mov_b64 exec, s[56:57]
  v_cmpx_eq_u64 vcc, v[96:97], v[240:241]
  v_cmpx_eq_u64 vcc, v[98:99], v[240:241]
  v_cmpx_eq_u64 vcc, v[100:101], v[240:241]
  v_cmpx_eq_u64 vcc, v[102:103], v[240:241]
  v_cmpx_eq_u64 vcc, v[104:105], v[240:241]
  v_cmpx_eq_u64 vcc, v[106:107], v[240:241]
  v_cmpx_eq_u64 vcc, v[108:109], v[240:241]
  v_cmpx_eq_u64 vcc, v[110:111], v[240:241]
  s_cmp_eq_u64 exec, s[56:57]
  s_cbranch_scc0 RETRY
  s_not_b64 exec, s[56:57]
  s_waitcnt lgkmcnt(0)
  s_nop 0
  v_mfma_f32_16x16x32_bf16 v[84:87], v[160:163], v[80:83], 0
  v_cvt_pk_bf16_f32 v88, v112, v113
  v_cvt_pk_bf16_f32 v89, v114, v115
  ds_write_b64 v198, v[88:89]
  v_cvt_pk_bf16_f32 v90, v116, v117
  v_cvt_pk_bf16_f32 v91, v118, v119
  ds_write_b64 v199, v[90:91]
  v_cvt_pk_bf16_f32 v92, v120, v121
  v_cvt_pk_bf16_f32 v93, v122, v123
  ds_write_b64 v200, v[92:93]
  v_cvt_pk_bf16_f32 v94, v124, v125
  v_cvt_pk_bf16_f32 v95, v126, v127
  ds_write_b64 v201, v[94:95]
  v_cvt_pk_bf16_f32 v24, v84, v85
  v_cvt_pk_bf16_f32 v25, v86, v87
  ds_write_b64 v202, v[24:25]
  s_mov_b64 exec, s[56:57]
  v_cmpx_eq_u64 vcc, v[80:81], v[240:241]
  v_cmpx_eq_u64 vcc, v[82:83], v[240:241]
  s_cmp_eq_u64 exec, s[56:57]
  s_mov_b64 exec, -1
  s_cbranch_scc0 RETRY
P2OK:
  s_waitcnt lgkmcnt(0)
  s_barrier
  ds_read_b64_tr_b16 v[128:129], v203 offset:0
  ds_read_b64_tr_b16 v[130:131], v203 offset:512
  ds_read_b64_tr_b16 v[132:133], v203 offset:1104
  ds_read_b64_tr_b16 v[134:135], v203 offset:1616
  ds_read_b64_tr_b16 v[136:137], v203 offset:2208
  ds_read_b64_tr_b16 v[138:139], v203 offset:2720
  ds_read_b64_tr_b16 v[140:141], v203 offset:3312
  ds_read_b64_tr_b16 v[142:143], v203 offset:3824
  ds_read_b64_tr_b16 v[144:145], v245 offset:4416
  ds_read_b64_tr_b16 v[146:147], v245 offset:4928
  s_waitcnt lgkmcnt(8)
  v_mfma_f32_16x16x32_bf16 v[32:35], v[164:167], v[128:131], 0
  ds_read_b64_tr_b16 v[148:149], v245 offset:5520
  ds_read_b64_tr_b16 v[150:151], v245 offset:6032
  s_waitcnt lgkmcnt(8)
  v_mfma_f32_16x16x32_bf16 v[36:39], v[168:171], v[132:135], 0
  ds_read_b64_tr_b16 v[152:153], v245 offset:6624
  ds_read_b64_tr_b16 v[154:155], v245 offset:7136
  s_waitcnt lgkmcnt(8)
  v_mfma_f32_16x16x32_bf16 v[40:43], v[172:175], v[136:139], 0
  s_mov_b64 exec, s[64:65]
  s_waitcnt lgkmcnt(6)
  v_mfma_f32_16x16x32_bf16 v[44:47], v[176:179], v[140:143], 0
  s_waitcnt lgkmcnt(4)
  v_mfma_f32_16x16x32_bf16 v[48:51], v[180:183], v[144:147], 0
  v_cvt_pk_bf16_f32 v220, v32, v36
  s_waitcnt lgkmcnt(2)
  v_mfma_f32_16x16x32_bf16 v[52:55], v[184:187], v[148:151], 0
  v_cvt_pk_bf16_f32 v224, v33, v37
  s_waitcnt lgkmcnt(0)
  v_mfma_f32_16x16x32_bf16 v[56:59], v[188:191], v[152:155], 0
  v_cvt_pk_bf16_f32 v228, v34, v38
  v_cvt_pk_bf16_f32 v232, v35, v39
  v_cvt_pk_bf16_f32 v221, v40, v44
  v_cvt_pk_bf16_f32 v225, v41, v45
  v_cvt_pk_bf16_f32 v229, v42, v46
  v_cvt_pk_bf16_f32 v233, v43, v47
  v_cvt_pk_bf16_f32 v222, v48, v52
  v_cvt_pk_bf16_f32 v226, v49, v53
  v_cvt_pk_bf16_f32 v223, v56, 0
  v_cvt_pk_bf16_f32 v227, v57, 0
  v_cvt_pk_bf16_f32 v230, v50, v54
  v_mfma_f32_16x16x32_bf16 v[64:67], v[192:195], v[220:223], 0
  v_cvt_pk_bf16_f32 v231, v58, 0
  v_mfma_f32_16x16x32_bf16 v[68:71], v[192:195], v[224:227], 0
  v_cvt_pk_bf16_f32 v234, v51, v55
  v_cvt_pk_bf16_f32 v235, v59, 0
  s_mov_b64 exec, -1
  s_nop 0
  v_mfma_f32_16x16x32_bf16 v[72:75], v[192:195], v[228:231], 0
  s_cmp_ge_u32 s2, 256
  v_mfma_f32_16x16x32_bf16 v[76:79], v[192:195], v[232:235], 0
  v_fmac_f32_dpp v64, v64, v205 row_ror:8 row_mask:0xf bank_mask:0xf
  v_fmac_f32_dpp v65, v65, v205 row_ror:8 row_mask:0xf bank_mask:0xf
  v_fmac_f32_dpp v66, v66, v205 row_ror:8 row_mask:0xf bank_mask:0xf
  v_fmac_f32_dpp v67, v67, v205 row_ror:8 row_mask:0xf bank_mask:0xf
  v_fmac_f32_dpp v68, v68, v205 row_ror:8 row_mask:0xf bank_mask:0xf
  v_fmac_f32_dpp v69, v69, v205 row_ror:8 row_mask:0xf bank_mask:0xf
  v_fmac_f32_dpp v70, v70, v205 row_ror:8 row_mask:0xf bank_mask:0xf
  v_fmac_f32_dpp v71, v71, v205 row_ror:8 row_mask:0xf bank_mask:0xf
  v_cvt_pk_bf16_f32 v96, v64, v68
  v_cvt_pk_bf16_f32 v98, v65, v69
  v_cvt_pk_bf16_f32 v100, v66, v70
  v_cvt_pk_bf16_f32 v102, v67, v71
  v_fmac_f32_dpp v72, v72, v205 row_ror:8 row_mask:0xf bank_mask:0xf
  v_fmac_f32_dpp v73, v73, v205 row_ror:8 row_mask:0xf bank_mask:0xf
  v_fmac_f32_dpp v74, v74, v205 row_ror:8 row_mask:0xf bank_mask:0xf
  v_fmac_f32_dpp v75, v75, v205 row_ror:8 row_mask:0xf bank_mask:0xf
  v_fmac_f32_dpp v76, v76, v205 row_ror:8 row_mask:0xf bank_mask:0xf
  v_fmac_f32_dpp v77, v77, v205 row_ror:8 row_mask:0xf bank_mask:0xf
  v_fmac_f32_dpp v78, v78, v205 row_ror:8 row_mask:0xf bank_mask:0xf
  v_fmac_f32_dpp v79, v79, v205 row_ror:8 row_mask:0xf bank_mask:0xf
  v_cvt_pk_bf16_f32 v97, v72, v76
  ds_write_b64 v204, v[96:97] offset:0
  v_cvt_pk_bf16_f32 v99, v73, v77
  ds_write_b64 v204, v[98:99] offset:32
  v_cvt_pk_bf16_f32 v101, v74, v78
  ds_write_b64 v243, v[100:101] offset:64
  v_cvt_pk_bf16_f32 v103, v75, v79
  ds_write_b64 v243, v[102:103] offset:96
  s_nop 0
  s_waitcnt lgkmcnt(0)
  s_barrier
  s_cbranch_scc1 XTAIL
  ds_read_b128 v[128:131], v206
  ds_read_b128 v[144:147], v211
  ds_read_b128 v[132:135], v207
  ds_read_b32 v136, v208
  ds_read_b128 v[148:151], v212
  ds_read_b32 v152, v213
  s_waitcnt lgkmcnt(5)
  buffer_store_dwordx4 v[128:131], v209, s[12:15], s53 offen sc0 sc1
  s_waitcnt lgkmcnt(4)
  buffer_store_dwordx4 v[144:147], v214, s[12:15], s53 offen sc0 sc1
  s_waitcnt lgkmcnt(2)
  v_bfi_b32 v140, s66, v136, v135
  v_bfi_b32 v141, s66, v135, v134
  v_bfi_b32 v142, s66, v134, v133
  v_bfi_b32 v143, s66, v133, v132
  buffer_store_dwordx4 v[140:143], v210, s[12:15], s53 offen sc0 sc1
  s_waitcnt lgkmcnt(0)
  v_bfi_b32 v156, s66, v152, v151
  v_bfi_b32 v157, s66, v151, v150
  v_bfi_b32 v158, s66, v150, v149
  v_bfi_b32 v159, s66, v149, v148
  buffer_store_dwordx4 v[156:159], v215, s[12:15], s53 offen sc0 sc1
XEND:
K_END:
  s_endpgm
NWAIT:
  s_add_u32 s59, s59, 1
  s_cmp_gt_u32 s59, 0x100000
  s_cbranch_scc1 NOK
  buffer_load_dwordx2 v[218:219], off, s[28:31], 0 sc1
  s_waitcnt vmcnt(0)
  v_cmp_eq_u32 vcc, 0, v218
  s_cbranch_vccnz NWAIT
  s_branch NOK
XENTRY:
  s_setprio 0
  v_bfrev_b32 v20, 1
  v_bfrev_b32_e64 v21, 1
  s_branch XTRA
XW1:
  s_waitcnt lgkmcnt(0)
  s_lshl_b32 s3, s8, 9
  s_add_u32 s3, s3, 2130048
  s_add_u32 s4, s3, 384
XW_L:
  buffer_load_dwordx2 v[218:219], off, s[28:31], 0 offset:128 sc1
  buffer_load_dwordx2 v[4:5], off, s[24:27], s3 sc1
  s_add_u32 s59, s59, 1
  s_cmp_gt_u32 s59, 0x100000
  s_cbranch_scc1 XW2
  s_add_u32 s3, s3, 128
  s_min_u32 s3, s3, s4
  s_waitcnt vmcnt(0)
  v_cmp_eq_u32 vcc, 0, v218
  s_cbranch_vccnz XW_L
  v_cmp_ne_u64 vcc, v[4:5], v[218:219]
  s_cbranch_vccnz XW_L
XW2:
  s_waitcnt vmcnt(0)
  s_mov_b32 vcc_lo, 0xff00ff00
  s_mov_b32 vcc_hi, 0xff00ff00
  v_cndmask_b32 v240, v218, v219, vcc
  v_cndmask_b32 v241, v218, v219, vcc
  s_branch RELOAD
XTAIL:
  s_cmp_lg_u32 s19, 0
  s_cbranch_scc1 XEND
  ds_read_b128 v[128:131], v206
  s_waitcnt lgkmcnt(0)
  buffer_store_dwordx4 v[128:131], v209, s[12:15], s53 offen sc0 sc1
  s_branch XEND
RELOAD:
  s_setprio 1
  s_mov_b32 s58, 0
  s_branch LOAD2
.fill 96, 4, 0xbf800000
.section .rodata,"a"
.p2align 6
.amdhsa_kernel concat_heads__spectral_fnet__spectral_fnet__prompt_kernel
.amdhsa_next_free_vgpr 248
.amdhsa_next_free_sgpr 102
.amdhsa_accum_offset 248
.amdhsa_group_segment_fixed_size 0
.amdhsa_kernarg_size 104
.amdhsa_user_sgpr_count 2
.amdhsa_user_sgpr_kernarg_segment_ptr 1
.amdhsa_system_sgpr_workgroup_id_x 1
.amdhsa_float_denorm_mode_32 3
.end_amdhsa_kernel
```
